```python
import torch

def _softmax(x, axis=-1):
    return torch.softmax(x, dim=axis)
def _gelu(x):
    return torch.nn.functional.gelu(x, approximate="tanh")
def _silu(x):
    return torch.nn.functional.silu(x)
def _sigmoid(x):
    return torch.sigmoid(x)
def _layernorm(x, axis=-1, eps=1e-5):
    m = x.mean(dim=axis, keepdim=True)
    v = x.var(dim=axis, keepdim=True, unbiased=False)
    return (x - m) / torch.sqrt(v + eps)
def _scatter_add(tgt, idx, src, axis=0):
    return tgt.clone().index_add_(axis, idx, src)
def _segment_sum(src, seg, n):
    out = torch.zeros((n,) + src.shape[1:], dtype=src.dtype)
    return out.index_add_(0, seg, src)
def _pad(x, pw):
    flat = tuple(v for pair in reversed(pw) for v in pair)
    return torch.nn.functional.pad(x, flat)

kernel_name = 'parallel_sum__sliding_block_cached__dense_activation_gelu__decode'

def setup_inputs():

    _w = (lambda a: (lambda t: t.to(torch.bfloat16) if t.is_floating_point() else t)(torch.as_tensor(a)))
    def _A_setup():
        B, Sq, D = 1, 1, 512
        Hq, Hkv, Sk, Dh = 32, 8, 65536, 128
        assert Hq % Hkv == 0, (Hq, Hkv)
        return {
            "x": _w((lambda *s: torch.randn(*s, dtype=torch.bfloat16) * 0.05)(B, Sq, D)),
            "k_cache": _w((lambda *s: torch.randn(*s, dtype=torch.bfloat16) * 1.6)(B, Hkv, Sk, Dh)),
            "v_cache": _w((lambda *s: torch.randn(*s, dtype=torch.bfloat16) * 0.8)(B, Hkv, Sk, Dh)),
            "wq": _w((lambda *s: torch.randn(*s, dtype=torch.bfloat16) * 1.6)(D, Hq * Dh) * (D ** -0.5)),
            "wo": _w((lambda *s: torch.randn(*s, dtype=torch.bfloat16) * 0.8)(Hq * Dh, D) * ((Hq * Dh) ** -0.5)),
        }
    _A_in = _A_setup()

    def _B_setup():
        B, S, D, F = 1, 1, 512, 1792
        return {
            "x": _w((lambda *s: torch.randn(*s, dtype=torch.bfloat16) * 0.05)(B, S, D)),
            "w1": _w((lambda *s: torch.randn(*s, dtype=torch.bfloat16) * 0.4)(D, F) * (D ** -0.5)),
            "b1": _w((lambda *s: torch.randn(*s, dtype=torch.bfloat16) * 0.4)(F) * 0.01),
            "w2": _w((lambda *s: torch.randn(*s, dtype=torch.bfloat16) * 0.4)(F, D) * (F ** -0.5)),
            "b2": _w((lambda *s: torch.randn(*s, dtype=torch.bfloat16) * 0.4)(D) * 0.01),
        }
    _B_in = _B_setup()

    return {
        "A_x": _A_in["x"],
        "A_k_cache": _A_in["k_cache"],
        "A_v_cache": _A_in["v_cache"],
        "A_wq": _A_in["wq"],
        "A_wo": _A_in["wo"],
        "B_x": _B_in["x"],
        "B_w1": _B_in["w1"],
        "B_b1": _B_in["b1"],
        "B_w2": _B_in["w2"],
        "B_b2": _B_in["b2"],
    }

def reference(A_x, A_k_cache, A_v_cache, A_wq, A_wo, B_x, B_w1, B_b1, B_w2, B_b2):
    def _A_ref(x, k_cache, v_cache, wq, wo):
        B, Sq, D = x.shape
        Hq, Dh = 32, 128
        Hkv, Sk = k_cache.shape[1], k_cache.shape[2]
        W = min(4096, max(256, Sk // 4))
        rep = Hq // Hkv
        q = (lambda x, *d: x.permute(*d))((x @ wq).reshape(B, Sq, Hq, Dh), 0, 2, 1, 3)
        k = (lambda x, n, axis: torch.repeat_interleave(x, n, dim=axis))(k_cache[:, :, Sk - W:, :], rep, axis=1)
        v = (lambda x, n, axis: torch.repeat_interleave(x, n, dim=axis))(v_cache[:, :, Sk - W:, :], rep, axis=1)
        scores = torch.einsum("bhqd,bhkd->bhqk", q, k) * (Dh ** -0.5)
        p = _softmax(scores, axis=-1)
        o = torch.einsum("bhqk,bhkd->bhqd", p, v)
        return (lambda x, *d: x.permute(*d))(o, 0, 2, 1, 3).reshape(B, Sq, Hq * Dh) @ wo

    def _B_ref(x, w1, b1, w2, b2):
        h = torch.einsum("bsd,df->bsf", x, w1) + b1
        h = _gelu(h)
        return torch.einsum("bsf,fd->bsd", h, w2) + b2

    x = A_x
    xn = _layernorm(x, axis=-1)
    return x + _A_ref(xn, A_k_cache, A_v_cache, A_wq, A_wo) + _B_ref(xn, B_w1, B_b1, B_w2, B_b2)
```

```asm
; @launch grid=(256,1,1) block=(576,1,1) lds=122880
.amdgcn_target "amdgcn-amd-amdhsa--gfx950"
.text
.globl parallel_sum__sliding_block_cached__dense_activation_gelu__decode_kernel
.p2align 8
.type parallel_sum__sliding_block_cached__dense_activation_gelu__decode_kernel,@function
parallel_sum__sliding_block_cached__dense_activation_gelu__decode_kernel:
    s_load_dwordx2 s[4:5], s[0:1], 0
    s_load_dwordx2 s[8:9], s[0:1], 24
    s_load_dwordx2 s[12:13], s[0:1], 8
    s_load_dwordx2 s[32:33], s[0:1], 96
    v_lshrrev_b32 v1, 6, v0
    v_and_b32 v0, 63, v0
    s_lshr_b32 s48, s2, 8
    v_readfirstlane_b32 s3, v1
    s_cbranch_scc1 L_end
    s_lshr_b32 s49, s2, 6
    s_and_b32 s51, s2, 7
    s_sub_u32 s3, s3, 1
    s_cbranch_scc0 L_att0
    s_movk_i32 s6, 1024
    s_mov_b32 s7, 0x20000
    v_lshlrev_b32 v1, 4, v0
    s_waitcnt lgkmcnt(0)
    buffer_load_dwordx4 v[12:15], v1, s[4:7], 0 offen
    s_load_dwordx2 s[24:25], s[0:1], 48
    s_branch L_aux
L_att0:
    v_lshlrev_b32 v2, 4, v0
    v_and_b32 v2, 0x70, v2
    v_lshlrev_b32 v3, 1, v0
    v_and_b32 v3, 32, v3
    v_xor_b32 v2, v2, v3
    v_lshrrev_b32 v3, 3, v0
    v_lshl_or_b32 v2, v3, 13, v2
    v_xor_b32 v4, 64, v2
    s_lshl_b32 s50, s49, 20
    s_lshl_b32 s52, s51, 10
    s_add_u32 s50, s50, s52
    s_bfe_u32 s53, s2, 0x30003
    s_lshl_b32 s52, s53, 7
    s_add_u32 s50, s50, s52
    s_lshl_b32 s52, s3, 17
    s_add_u32 s50, s50, s52
    s_add_u32 s54, s50, 0x10000
    s_lshl_b32 m0, s3, 11
    s_mov_b32 s10, 0x400000
    s_mov_b32 s11, 0x20000
    s_waitcnt lgkmcnt(0)
    buffer_load_dwordx4 v2, s[8:11], s50 offen nt lds
    s_add_u32 m0, m0, 0x400
    s_nop 0
    buffer_load_dwordx4 v4, s[8:11], s54 offen nt lds
L_entry_end:
    s_load_dwordx2 s[16:17], s[0:1], 16
    s_load_dwordx2 s[20:21], s[0:1], 32
    v_lshrrev_b32 v5, 4, v0
    v_and_b32 v1, 15, v0
    v_xor_b32 v6, v1, v5
    v_lshlrev_b32 v6, 4, v6
    v_lshl_or_b32 v6, v5, 8, v6
    s_lshr_b32 s55, s2, 3
    s_lshl_b32 s56, s51, 24
    s_lshl_b32 s52, s55, 15
    s_add_u32 s56, s56, s52
    s_lshl_b32 s52, s3, 12
    s_add_u32 s56, s56, s52
    s_add_u32 s56, s56, 0xf00000
    s_add_u32 s64, s52, 16384
    s_add_u32 s65, s52, 49152
    s_mov_b32 s14, 0x8000000
    s_mov_b32 s15, s11
    s_lshl_b32 s36, s2, 10
    s_and_b32 s36, s36, 0xc00
    s_add_u32 s24, s56, s36
    s_lshr_b32 s52, s36, 4
    v_xor_b32 v95, s52, v6
    s_add_u32 m0, s64, s36
    s_nop 0
    buffer_load_dwordx4 v95, s[12:15], s24 offen nt lds
    s_waitcnt lgkmcnt(0)
    s_load_dword s59, s[32:33], 0
    s_mov_b32 s18, s14
    s_mov_b32 s19, s11
    s_mov_b32 s22, s10
    s_mov_b32 s23, s11
    s_mov_b32 s34, 0x200000
    s_mov_b32 s35, s11
    s_movk_i32 s60, 0xff
    s_mov_b32 s63, 0xffffff00
    s_mov_b32 s70, 0
    s_mov_b32 s28, 0x000f000f
    s_mov_b32 s29, s28
    s_mov_b32 s30, 0x00010001
    s_mov_b32 s31, s30
    s_add_u32 s37, s36, 0x400
    s_and_b32 s37, s37, 0xc00
    s_add_u32 s25, s56, s37
    s_lshr_b32 s52, s37, 4
    v_xor_b32 v7, s52, v6
    s_add_u32 s38, s37, 0x400
    s_and_b32 s38, s38, 0xc00
    s_add_u32 s26, s56, s38
    s_lshr_b32 s52, s38, 4
    v_xor_b32 v38, s52, v6
    s_add_u32 s39, s38, 0x400
    s_and_b32 s39, s39, 0xc00
    s_add_u32 s27, s56, s39
    s_lshr_b32 s52, s39, 4
    v_xor_b32 v39, s52, v6
    v_lshlrev_b32 v40, 1, v5
    v_xor_b32 v40, v1, v40
    v_lshlrev_b32 v40, 4, v40
    v_lshl_or_b32 v40, v5, 8, v40
    s_lshr_b32 s52, s36, 4
    s_and_b32 s52, s52, 0x80
    v_xor_b32 v8, s52, v40
    s_lshr_b32 s52, s37, 4
    s_and_b32 s52, s52, 0x80
    v_xor_b32 v9, s52, v40
    s_lshr_b32 s52, s38, 4
    s_and_b32 s52, s52, 0x80
    v_xor_b32 v86, s52, v40
    s_lshr_b32 s52, s39, 4
    s_and_b32 s52, s52, 0x80
    v_xor_b32 v87, s52, v40
    v_mov_b32 v88, 120704
    v_lshrrev_b32 v2, 2, v1
    v_and_b32 v3, 3, v0
    s_and_b32 s52, s3, 3
    s_lshl_b32 s62, s52, 5
    v_lshl_add_u32 v11, v5, 3, v2
    v_lshlrev_b32 v21, 8, v11
    v_lshlrev_b32 v11, 7, v11
    v_lshlrev_b32 v40, 3, v3
    v_and_b32 v41, 2, v2
    v_lshlrev_b32 v41, 4, v41
    v_and_b32 v42, 1, v5
    v_lshlrev_b32 v43, 6, v42
    v_or_b32 v43, v41, v43
    v_xor_b32 v44, v40, v43
    v_xor_b32 v44, s62, v44
    v_or_b32 v11, v11, v44
    s_lshl_b32 s52, s49, 8
    s_add_u32 s52, s52, 114688
    v_lshl_add_u32 v12, v5, 4, s52
    s_cmp_ge_u32 s3, 4
    s_cselect_b32 s52, 0x40000000, 0
    v_lshl_add_u32 v13, v5, 4, s52
    s_getreg_b32 s57, hwreg(HW_REG_XCC_ID, 0, 3)
    s_lshl_b32 s57, s57, 5
    s_lshl_b32 s67, s51, 13
    s_add_u32 s67, s67, 0x10000
    s_lshl_b32 s52, s49, 11
    s_add_u32 s68, s67, s52
    s_lshl_b32 s52, s53, 8
    s_add_u32 s68, s68, s52
    s_lshl_b32 s52, s62, 1
    s_add_u32 s68, s68, s52
    s_lshl_b32 s52, s3, 8
    s_add_u32 s67, s67, s52
    v_lshlrev_b32 v14, 4, v1
    v_lshl_or_b32 v14, v5, 11, v14
    s_and_b32 s46, s68, 0xffffff00
    s_waitcnt vmcnt(2)
    s_add_u32 m0, s64, s37
    s_nop 0
    buffer_load_dwordx4 v7, s[12:15], s25 offen nt lds
    s_waitcnt vmcnt(2)
    s_add_u32 m0, s64, s38
    s_nop 0
    buffer_load_dwordx4 v38, s[12:15], s26 offen nt lds
    s_waitcnt lgkmcnt(0)
    s_add_u32 s59, s59, 1
    s_lshr_b32 s48, s59, 7
    s_and_b32 s48, s48, 0xfe
    s_or_b32 s48, s48, 1
    s_and_b32 s59, s59, 0xff
    s_xor_b32 s73, s59, s48
    v_mov_b32 v10, s59
    v_mov_b32 v105, s73
    v_xor_b32 v94, s57, v105
    s_barrier
    s_add_u32 m0, s64, s39
    s_nop 0
    buffer_load_dwordx4 v39, s[12:15], s27 offen nt lds
    s_cmp_ge_u32 s3, 4
    s_cbranch_scc1 L_qskip
    ds_read_b64_tr_b16 v[40:41], v11 offset:0
    ds_read_b64_tr_b16 v[42:43], v11 offset:512
    ds_read_b128 v[56:59], v12 offset:0
    ds_read_b64_tr_b16 v[44:45], v11 offset:4096
    ds_read_b64_tr_b16 v[46:47], v11 offset:4608
    ds_read_b128 v[60:63], v12 offset:64
    ds_read_b64_tr_b16 v[48:49], v11 offset:8192
    ds_read_b64_tr_b16 v[50:51], v11 offset:8704
    ds_read_b128 v[64:67], v12 offset:128
    ds_read_b64_tr_b16 v[52:53], v11 offset:12288
    ds_read_b64_tr_b16 v[54:55], v11 offset:12800
    ds_read_b128 v[68:71], v12 offset:192
    s_waitcnt lgkmcnt(9)
    v_mfma_f32_16x16x32_bf16 v[72:75], v[40:43], v[56:59], 0
    s_waitcnt lgkmcnt(6)
    v_mfma_f32_16x16x32_bf16 v[72:75], v[44:47], v[60:63], v[72:75]
    s_waitcnt lgkmcnt(3)
    v_mfma_f32_16x16x32_bf16 v[72:75], v[48:51], v[64:67], v[72:75]
    s_waitcnt lgkmcnt(0)
    v_mfma_f32_16x16x32_bf16 v[72:75], v[52:55], v[68:71], v[72:75]
    s_mov_b64 exec, s[30:31]
    s_nop 6
    v_and_or_b32 v90, v72, s63, v10
    v_and_or_b32 v91, v73, s63, v105
    v_and_or_b32 v92, v74, s63, v10
    v_and_or_b32 v93, v75, s63, v94
L_qskip:
    s_mov_b64 exec, s[30:31]
    buffer_store_dwordx4 v[90:93], v13, s[32:35], s68 offen
    s_mov_b64 exec, -1
    s_barrier
    v_lshlrev_b32 v60, 3, v3
    v_and_b32 v62, 1, v5
    v_lshlrev_b32 v66, 5, v2
    v_lshl_or_b32 v67, v62, 7, v66
    v_xor_b32 v67, v67, v60
    s_lshl_b32 s61, s3, 5
    v_xor_b32 v67, s61, v67
    v_or_b32 v21, v21, v67
    v_add_u32 v21, 49152, v21
    s_lshl_b32 s48, s3, 11
    s_add_u32 s66, s48, 81920
    s_add_u32 s58, s66, 0x400
    v_lshl_add_u32 v29, v2, 2, v5
    v_lshlrev_b32 v29, 7, v29
    v_or3_b32 v29, v29, v66, v60
    v_add_u32 v29, s66, v29
    v_xor_b32 v30, 32, v29
    v_xor_b32 v31, 64, v29
    v_xor_b32 v32, 0x60, v29
    s_lshr_b32 s52, s3, 1
    s_mul_i32 s52, s52, 288
    s_and_b32 s47, s3, 1
    s_lshl_b32 s47, s47, 7
    s_add_u32 s52, s52, s47
    s_add_u32 s52, s52, 115712
    v_lshl_add_u32 v15, v1, 2, v5
    v_lshl_add_u32 v15, v15, 1, s52
    v_mul_u32_u24 v65, 288, v3
    v_lshl_add_u32 v16, v5, 4, v65
    v_add_u32 v16, 115712, v16
    s_add_u32 s52, s61, 116864
    v_lshl_add_u32 v22, v5, 3, v65
    v_add_u32 v22, s52, v22
    v_lshlrev_b32 v24, 2, v3
    v_add_u32 v24, 118016, v24
    v_mov_b32 v108, 0x3f803f80
    v_mov_b32 v109, 0x3f803f80
    v_mov_b32 v110, 0x3f803f80
    v_mov_b32 v111, 0x3f803f80
    v_xor_b32 v17, v1, v5
    v_lshlrev_b32 v17, 4, v17
    v_lshl_or_b32 v17, v1, 8, v17
    v_add_u32 v17, s64, v17
    v_xor_b32 v18, 64, v17
    v_xor_b32 v19, 0x80, v17
    v_xor_b32 v20, 0xc0, v17
    v_lshlrev_b32 v25, 14, v3
    v_lshl_or_b32 v25, v5, 4, v25
    v_lshlrev_b32 v26, 9, v3
    v_lshlrev_b32 v27, 4, v0
    v_lshlrev_b32 v28, 2, v0
    v_and_b32 v28, 0xf0, v28
    v_and_b32 v36, 0x70, v27
    v_and_b32 v66, 32, v0
    v_xor_b32 v36, v36, v66
    v_lshrrev_b32 v66, 3, v0
    v_lshl_or_b32 v36, v66, 10, v36
    v_xor_b32 v37, 64, v36
    s_lshl_b32 s52, s3, 8
    s_add_u32 s52, s52, 118272
    v_lshl_add_u32 v33, v0, 2, s52
    s_lshl_b32 s52, s51, 16
    s_add_u32 s52, s52, s48
    s_add_u32 s52, s52, 0x80000
    s_lshl_b32 s44, s55, 6
    s_add_u32 s44, s44, s52
    s_lshl_b32 s61, s49, 14
    s_add_u32 s61, s61, s52
    s_lshl_b32 s52, s51, 11
    s_add_u32 s52, s52, 0x30000
    s_lshl_b32 s45, s55, 4
    s_add_u32 s45, s45, s52
    s_lshl_b32 s62, s49, 9
    s_add_u32 s62, s62, s52
    s_lshl_b32 s52, s51, 2
    s_add_u32 s52, s52, s49
    s_lshl_b32 s50, s52, 17
    s_lshl_b32 s48, s3, 14
    s_add_u32 s50, s50, s48
    s_lshl_b32 s48, s53, 7
    s_add_u32 s50, s50, s48
    s_add_u32 s54, s50, 8192
    s_mov_b32 s40, 0x11111111
    s_mov_b32 s41, s40
    s_and_b32 s48, s51, 1
    s_lshl_b32 s52, s48, 13
    s_xor_b32 s50, s50, s52
    s_xor_b32 s54, s54, s52
    s_lshl_b32 s52, s48, 10
    s_xor_b32 s66, s66, s52
    s_xor_b32 s58, s58, s52
    s_lshl_b32 s52, s48, 6
    v_xor_b32 v36, s52, v36
    v_xor_b32 v37, s52, v37
    s_waitcnt vmcnt(3)
    s_add_u32 m0, s65, s36
    s_nop 0
    buffer_load_dwordx4 v8, s[16:19], s24 offen nt lds
    s_waitcnt vmcnt(3)
    s_add_u32 m0, s65, s37
    s_nop 0
    buffer_load_dwordx4 v9, s[16:19], s25 offen nt lds
    s_waitcnt vmcnt(3)
    buffer_load_dwordx4 v[76:79], v14, s[32:35], s67 offen nt
    s_waitcnt vmcnt(4)
    ds_read_b128 v[40:43], v17
    ds_read_b128 v[44:47], v18
    ds_read_b128 v[48:51], v19
    ds_read_b128 v[52:55], v20
    s_waitcnt vmcnt(2)
    s_add_u32 m0, s65, s38
    s_nop 0
    buffer_load_dwordx4 v86, s[16:19], s26 offen nt lds
    buffer_load_dwordx4 v[96:99], v14, s[32:35], s67 offen nt
    s_waitcnt vmcnt(3)
    s_add_u32 m0, s65, s39
    s_nop 0
    buffer_load_dwordx4 v87, s[16:19], s27 offen nt lds
    s_waitcnt vmcnt(3)
L_qchk:
    v_xor_b32 v82, s57, v79
    v_bitop3_b32 v80, v76, v78, s59 bitop3:0x7e
    v_bitop3_b32 v81, v77, v82, s73 bitop3:0x7e
    v_bitop3_b32 v83, v80, v81, s60 bitop3:0xa8
    v_cmp_ne_u32 vcc, 0, v83
    s_cbranch_vccnz L_qslow
L_qok:
    v_and_b32 v76, s63, v76
    v_and_b32 v77, s63, v77
    v_and_b32 v78, s63, v78
    v_and_b32 v79, s63, v79
    s_nop 0
    v_permlane32_swap_b32 v76, v78
    v_permlane32_swap_b32 v77, v79
    v_add_f32 v76, v76, v78
    v_add_f32 v77, v77, v79
    s_nop 1
    v_permlane16_swap_b32 v76, v77
    v_add_f32 v76, v76, v77
    v_cvt_pk_bf16_f32 v76, v76, v76
    ds_write_b16 v15, v76
    s_waitcnt lgkmcnt(0)
    s_barrier
    ds_read_b128 v[56:59], v16 offset:0
    ds_read_b128 v[60:63], v16 offset:64
    ds_read_b128 v[64:67], v16 offset:128
    ds_read_b128 v[68:71], v16 offset:192
    s_mov_b32 s48, 0x3db504f3
    s_mov_b32 s49, s48
    s_mov_b32 s52, 0xffff0000
    s_waitcnt lgkmcnt(3)
    v_mfma_f32_16x16x32_bf16 v[72:75], v[40:43], v[56:59], 0
    s_waitcnt lgkmcnt(2)
    v_mfma_f32_16x16x32_bf16 v[72:75], v[44:47], v[60:63], v[72:75]
    s_waitcnt lgkmcnt(1)
    v_mfma_f32_16x16x32_bf16 v[72:75], v[48:51], v[64:67], v[72:75]
    s_waitcnt lgkmcnt(0)
    v_mfma_f32_16x16x32_bf16 v[72:75], v[52:55], v[68:71], v[72:75]
    ds_read_b32 v94, v88 offset:4
    s_nop 6
    v_cvt_pk_bf16_f32 v76, v72, v73
    v_cvt_pk_bf16_f32 v77, v74, v75
    v_lshlrev_b32 v72, 16, v76
    v_and_b32 v73, s52, v76
    v_lshlrev_b32 v74, 16, v77
    v_and_b32 v75, s52, v77
    v_pk_mul_f32 v[72:73], v[72:73], s[48:49]
    v_pk_mul_f32 v[74:75], v[74:75], s[48:49]
    v_cvt_pk_bf16_f32 v76, v72, v73
    v_cvt_pk_bf16_f32 v77, v74, v75
    v_lshlrev_b32 v72, 16, v76
    v_and_b32 v73, s52, v76
    v_lshlrev_b32 v74, 16, v77
    v_and_b32 v75, s52, v77
    v_max3_f32 v76, v72, v73, v74
    v_max_f32 v76, v76, v75
    s_mov_b64 exec, s[28:29]
    ds_max_f32 v24, v76
    s_mov_b64 exec, -1
    s_waitcnt lgkmcnt(0)
    s_barrier
    ds_read_b32 v84, v24
    s_mov_b32 m0, s66
    s_nop 0
    buffer_load_dwordx4 v36, s[20:23], s50 offen nt lds
    s_mov_b32 s48, 0x3fb8aa3b
    v_readfirstlane_b32 s69, v94
    s_waitcnt lgkmcnt(0)
    v_mul_f32 v85, s48, v84
    v_fma_f32 v72, v72, s48, -v85
    v_fma_f32 v73, v73, s48, -v85
    v_fma_f32 v74, v74, s48, -v85
    v_fma_f32 v75, v75, s48, -v85
    v_exp_f32 v72, v72
    v_exp_f32 v73, v73
    v_exp_f32 v74, v74
    v_exp_f32 v75, v75
    s_mov_b64 exec, s[28:29]
    v_cvt_pk_bf16_f32 v76, v72, v73
    v_cvt_pk_bf16_f32 v77, v74, v75
    ds_write_b64 v22, v[76:77]
    s_mov_b64 exec, -1
    s_waitcnt vmcnt(1) lgkmcnt(0)
    s_barrier
    ds_read_b128 v[56:59], v16 offset:1152
    ds_read_b64_tr_b16 v[40:41], v21 offset:0
    ds_read_b64_tr_b16 v[42:43], v21 offset:1024
    ds_read_b128 v[60:63], v16 offset:1216
    ds_read_b64_tr_b16 v[44:45], v21 offset:8192
    ds_read_b64_tr_b16 v[46:47], v21 offset:9216
    ds_read_b128 v[64:67], v16 offset:1280
    ds_read_b64_tr_b16 v[48:49], v21 offset:16384
    ds_read_b64_tr_b16 v[50:51], v21 offset:17408
    ds_read_b128 v[68:71], v16 offset:1344
    ds_read_b64_tr_b16 v[52:53], v21 offset:24576
    ds_read_b64_tr_b16 v[54:55], v21 offset:25600
    s_cmp_lg_u32 s69, 0
    s_cbranch_scc1 L_remote
L_pv:
    s_waitcnt lgkmcnt(9)
    v_mfma_f32_16x16x32_bf16 v[72:75], v[40:43], v[56:59], 0
    s_waitcnt lgkmcnt(6)
    v_mfma_f32_16x16x32_bf16 v[72:75], v[44:47], v[60:63], v[72:75]
    s_waitcnt lgkmcnt(3)
    v_mfma_f32_16x16x32_bf16 v[72:75], v[48:51], v[64:67], v[72:75]
    s_waitcnt lgkmcnt(0)
    v_mfma_f32_16x16x32_bf16 v[72:75], v[52:55], v[68:71], v[72:75]
    s_cmp_lg_u32 s3, 0
    s_cbranch_scc1 L_pvrest
    v_mfma_f32_16x16x32_bf16 v[80:83], v[108:111], v[56:59], 0
    v_mfma_f32_16x16x32_bf16 v[80:83], v[108:111], v[60:63], v[80:83]
    v_mfma_f32_16x16x32_bf16 v[80:83], v[108:111], v[64:67], v[80:83]
    v_mfma_f32_16x16x32_bf16 v[80:83], v[108:111], v[68:71], v[80:83]
    s_mov_b64 exec, s[28:29]
    s_cmp_lg_u32 s69, 0
    s_nop 1
    v_and_or_b32 v76, v72, s63, v10
    v_and_or_b32 v77, v73, s63, v105
    v_and_or_b32 v78, v74, s63, v10
    v_and_or_b32 v79, v75, s63, v105
    s_cbranch_scc1 L_og0
    buffer_store_dwordx4 v[76:79], v25, s[32:35], s44 offen
    s_nop 0
    v_and_or_b32 v81, v80, s63, v105
    v_and_or_b32 v80, v84, s63, v10
    v_mov_b32 v82, v10
    v_mov_b32 v83, v105
    s_mov_b64 exec, 15
    buffer_store_dwordx4 v[80:83], v26, s[32:35], s45 offen
    s_branch L_opubd
L_pvrest:
    s_mov_b64 exec, s[28:29]
    s_cmp_lg_u32 s69, 0
    s_nop 5
    v_and_or_b32 v76, v72, s63, v10
    v_and_or_b32 v77, v73, s63, v105
    v_and_or_b32 v78, v74, s63, v10
    v_and_or_b32 v79, v75, s63, v105
    s_cbranch_scc1 L_og1
    buffer_store_dwordx4 v[76:79], v25, s[32:35], s44 offen
L_opubd:
    s_mov_b64 exec, -1
    s_barrier
    buffer_load_dwordx4 v[40:43], v27, s[32:35], s61 offen nt
    buffer_load_dwordx4 v[44:47], v27, s[32:35], s61 offen offset:1024 nt
    s_mov_b64 exec, s[40:41]
    buffer_load_dwordx4 v[48:51], v28, s[32:35], s62 offen nt
    buffer_load_dwordx4 v[52:55], v28, s[32:35], s62 offen offset:256 nt
    s_mov_b64 exec, -1
    s_mov_b32 m0, s58
    s_nop 0
    buffer_load_dwordx4 v37, s[20:23], s54 offen nt lds
    s_waitcnt vmcnt(1)
L_ochk:
    v_bitop3_b32 v68, v48, v50, s59 bitop3:0x7e
    v_bitop3_b32 v69, v49, v51, s73 bitop3:0x7e
    v_bitop3_b32 v70, v52, v54, s59 bitop3:0x7e
    v_or3_b32 v68, v68, v69, v70
    v_bitop3_b32 v69, v53, v55, s73 bitop3:0x7e
    v_or_b32 v68, v68, v69
    v_bitop3_b32 v56, v40, v42, s59 bitop3:0x7e
    v_bitop3_b32 v57, v41, v43, s73 bitop3:0x7e
    v_bitop3_b32 v58, v44, v46, s59 bitop3:0x7e
    v_or3_b32 v56, v56, v57, v58
    v_bitop3_b32 v57, v45, v47, s73 bitop3:0x7e
    v_or_b32 v56, v56, v57
    v_cndmask_b32 v68, 0, v68, s[40:41]
    v_bitop3_b32 v56, v56, v68, s60 bitop3:0xa8
    v_cmp_ne_u32 vcc, 0, v56
    s_cbranch_vccnz L_oretry
L_ook:
    v_and_b32 v48, s63, v48
    v_and_b32 v49, s63, v49
    v_and_b32 v52, s63, v52
    v_and_b32 v53, s63, v53
    v_max_f32 v56, v48, v52
    s_mov_b32 s48, 0x3fb8aa3b
    v_and_b32 v40, s63, v40
    v_and_b32 v41, s63, v41
    v_and_b32 v42, s63, v42
    v_and_b32 v43, s63, v43
    v_and_b32 v44, s63, v44
    v_and_b32 v45, s63, v45
    v_and_b32 v46, s63, v46
    v_and_b32 v47, s63, v47
    v_max_f32_dpp v56, v56, v56 row_ror:4 row_mask:0xf bank_mask:0xf
    s_nop 1
    v_max_f32_dpp v56, v56, v56 row_ror:8 row_mask:0xf bank_mask:0xf
    v_mov_b32 v57, v56
    s_nop 1
    v_permlane16_swap_b32 v56, v57
    v_max_f32 v56, v56, v57
    v_mov_b32 v57, v56
    s_nop 1
    v_permlane32_swap_b32 v56, v57
    v_max_f32 v56, v56, v57
    v_sub_f32 v48, v48, v56
    v_sub_f32 v52, v52, v56
    v_mul_f32 v48, s48, v48
    v_mul_f32 v52, s48, v52
    v_exp_f32 v48, v48
    v_exp_f32 v52, v52
    s_waitcnt vmcnt(0)
    ds_read_b64_tr_b16 v[60:61], v29
    ds_read_b64_tr_b16 v[62:63], v30
    ds_read_b64_tr_b16 v[64:65], v31
    ds_read_b64_tr_b16 v[66:67], v32
    v_mul_f32 v57, v48, v49
    v_fmac_f32 v57, v52, v53
    v_mul_f32_dpp v40, v48, v40 quad_perm:[0,0,0,0] row_mask:0xf bank_mask:0xf
    v_mul_f32_dpp v41, v48, v41 quad_perm:[0,0,0,0] row_mask:0xf bank_mask:0xf
    v_mul_f32_dpp v42, v48, v42 quad_perm:[0,0,0,0] row_mask:0xf bank_mask:0xf
    v_mul_f32_dpp v43, v48, v43 quad_perm:[0,0,0,0] row_mask:0xf bank_mask:0xf
    v_fmac_f32_dpp v40, v52, v44 quad_perm:[0,0,0,0] row_mask:0xf bank_mask:0xf
    v_fmac_f32_dpp v41, v52, v45 quad_perm:[0,0,0,0] row_mask:0xf bank_mask:0xf
    v_fmac_f32_dpp v42, v52, v46 quad_perm:[0,0,0,0] row_mask:0xf bank_mask:0xf
    v_fmac_f32_dpp v43, v52, v47 quad_perm:[0,0,0,0] row_mask:0xf bank_mask:0xf
    v_add_f32_dpp v57, v57, v57 row_ror:4 row_mask:0xf bank_mask:0xf
    v_permlane32_swap_b32 v40, v42
    v_permlane32_swap_b32 v41, v43
    v_add_f32_dpp v57, v57, v57 row_ror:8 row_mask:0xf bank_mask:0xf
    v_add_f32 v40, v40, v42
    v_add_f32 v41, v41, v43
    v_mov_b32 v58, v57
    s_nop 0
    v_permlane16_swap_b32 v40, v41
    v_permlane16_swap_b32 v57, v58
    v_add_f32 v40, v40, v41
    v_add_f32 v57, v57, v58
    v_mov_b32 v58, v57
    s_nop 0
    v_add_f32_dpp v40, v40, v40 row_ror:4 row_mask:0xf bank_mask:0xf
    v_permlane32_swap_b32 v57, v58
    v_add_f32 v57, v57, v58
    v_add_f32_dpp v40, v40, v40 row_ror:8 row_mask:0xf bank_mask:0xf
    v_rcp_f32 v57, v57
    s_nop 1
    v_mul_f32_dpp v40, v57, v40 quad_perm:[0,0,0,0] row_mask:0xf bank_mask:0xf
    s_nop 1
    v_mov_b32_dpp v44, v40 quad_perm:[0,0,0,0] row_mask:0xf bank_mask:0xf
    v_mov_b32_dpp v45, v40 quad_perm:[1,1,1,1] row_mask:0xf bank_mask:0xf
    v_mov_b32_dpp v46, v40 quad_perm:[2,2,2,2] row_mask:0xf bank_mask:0xf
    v_mov_b32_dpp v47, v40 quad_perm:[3,3,3,3] row_mask:0xf bank_mask:0xf
    v_cvt_pk_bf16_f32 v48, v44, v45
    v_cvt_pk_bf16_f32 v49, v46, v47
    s_waitcnt lgkmcnt(0)
    s_nop 0
    v_mfma_f32_16x16x16_bf16 v[68:71], v[48:49], v[60:61], 0
    v_mfma_f32_16x16x16_bf16 v[72:75], v[48:49], v[62:63], 0
    v_mfma_f32_16x16x16_bf16 v[76:79], v[48:49], v[64:65], 0
    v_mfma_f32_16x16x16_bf16 v[80:83], v[48:49], v[66:67], 0
    s_mov_b32 s64, 0xffff0000
    s_mov_b32 s65, 0
    s_mov_b32 s66, 0
    s_mov_b32 s67, 0xffff
    s_mov_b32 s68, 0
    s_mov_b32 s69, s64
    v_cndmask_b32 v68, v68, v72, s[64:65]
    s_nop 0
    v_cndmask_b32 v68, v68, v76, s[66:67]
    v_cndmask_b32 v68, v68, v80, s[68:69]
    ds_write_b32 v33, v68
    s_waitcnt lgkmcnt(0)
    s_barrier
    s_endpgm
L_qslow:
    v_xor_b32 v81, s73, v77
    v_xor_b32 v82, s73, v79
    v_and_b32 v82, 31, v82
    v_or3_b32 v83, v80, v81, v82
    v_and_b32 v83, s60, v83
    v_cmp_ne_u32 vcc, 0, v83
    s_cbranch_vccz L_qrem
    s_add_u32 s70, s70, 1
    s_cmp_eq_u32 s70, 1
    s_cbranch_scc0 L_qn0
    s_waitcnt vmcnt(1)
    v_mov_b32 v76, v96
    v_mov_b32 v77, v97
    v_mov_b32 v78, v98
    v_mov_b32 v79, v99
    s_branch L_qchk
L_qn0:
    s_and_b32 s48, s70, 15
    s_cmp_eq_u32 s48, 8
    s_cbranch_scc0 L_qnog
    s_mov_b32 exec_lo, 0xffff
    s_mov_b32 exec_hi, 0x0
    buffer_load_dwordx4 v[90:93], v27, s[32:35], s46 offen sc1
    s_add_u32 s47, s46, 0x60000
    s_waitcnt vmcnt(0)
    buffer_store_dwordx4 v[90:93], v27, s[32:35], s47 offen sc1
    s_mov_b64 exec, -1
L_qnog:
    s_cmp_lt_u32 s70, 8
    s_cbranch_scc0 L_qwide
    buffer_load_dwordx4 v[76:79], v14, s[32:35], s67 offen nt
    s_waitcnt vmcnt(0)
    s_branch L_qchk
L_qwide:
    s_cmp_eq_u32 s48, 0
    s_cselect_b32 s48, 0x60000, 0
    s_add_u32 s48, s48, s67
    buffer_load_dwordx4 v[76:79], v14, s[32:35], s48 offen sc1
    s_cmp_lt_u32 s70, 0x80000
    s_waitcnt vmcnt(0)
    s_cbranch_scc1 L_qchk
L_qrem:
    v_mov_b32 v80, 1
    ds_write_b32 v88, v80 offset:4
    s_branch L_qok
L_remote:
    s_mov_b32 exec_lo, 0xffff
    s_mov_b32 exec_hi, 0x0
    buffer_load_dwordx4 v[90:93], v27, s[32:35], s46 offen sc1
    s_add_u32 s47, s46, 0x60000
    s_waitcnt vmcnt(0)
    buffer_store_dwordx4 v[90:93], v27, s[32:35], s47 offen sc1
    s_mov_b64 exec, -1
    s_add_u32 s44, s44, 0x100000
    s_add_u32 s45, s45, 0x100000
    s_add_u32 s61, s61, 0x100000
    s_add_u32 s62, s62, 0x100000
    s_branch L_pv
L_og0:
    buffer_store_dwordx4 v[76:79], v25, s[32:35], s44 offen sc1
    s_nop 0
    v_and_or_b32 v81, v80, s63, v105
    v_and_or_b32 v80, v84, s63, v10
    v_mov_b32 v82, v10
    v_mov_b32 v83, v105
    s_mov_b64 exec, 15
    buffer_store_dwordx4 v[80:83], v26, s[32:35], s45 offen sc1
    s_branch L_opubd
L_og1:
    buffer_store_dwordx4 v[76:79], v25, s[32:35], s44 offen sc1
    s_branch L_opubd
L_oretry:
    s_add_u32 s70, s70, 1
    s_lshl_b32 s48, s69, 8
    s_add_u32 s48, s48, s70
    s_cmp_lt_u32 s48, 24
    s_cbranch_scc0 L_owide
    s_mov_b64 exec, vcc
    buffer_load_dwordx4 v[40:43], v27, s[32:35], s61 offen nt
    buffer_load_dwordx4 v[44:47], v27, s[32:35], s61 offen offset:1024 nt
    s_and_b64 exec, vcc, s[40:41]
    buffer_load_dwordx4 v[48:51], v28, s[32:35], s62 offen nt
    buffer_load_dwordx4 v[52:55], v28, s[32:35], s62 offen offset:256 nt
    s_mov_b64 exec, -1
    s_waitcnt vmcnt(0)
    s_branch L_ochk
L_owide:
    s_mov_b64 exec, vcc
    buffer_load_dwordx4 v[40:43], v27, s[32:35], s61 offen sc1
    buffer_load_dwordx4 v[44:47], v27, s[32:35], s61 offen offset:1024 sc1
    s_and_b64 exec, vcc, s[40:41]
    buffer_load_dwordx4 v[48:51], v28, s[32:35], s62 offen sc1
    buffer_load_dwordx4 v[52:55], v28, s[32:35], s62 offen offset:256 sc1
    s_mov_b64 exec, -1
    s_cmp_lt_u32 s70, 0x80000
    s_waitcnt vmcnt(0)
    s_cbranch_scc1 L_ochk
    s_branch L_ook
L_aux:
    s_setprio 3
    s_mov_b32 s34, 0x200000
    s_mov_b32 s35, s7
    s_lshr_b32 s55, s2, 3
    s_and_b32 s53, s55, 7
    s_mov_b32 s71, 0xffff0000
    v_add_u32 v9, 114688, v1
    s_cmp_ge_u32 s2, 16
    s_cselect_b32 s52, 0x40000000, 0
    s_getpc_b64 s[64:65]
L_pcref:
    s_sub_u32 s64, s64, L_pcref-parallel_sum__sliding_block_cached__dense_activation_gelu__decode_kernel
    s_subb_u32 s65, s65, 0
    s_mov_b32 s66, L_codeend-parallel_sum__sliding_block_cached__dense_activation_gelu__decode_kernel
    s_mov_b32 s67, s7
    v_lshl_add_u32 v2, v0, 7, s52
    buffer_load_dword v38, v2, s[64:67], 0 offen offset:256
    v_mov_b32 v88, 120704
    v_mov_b32 v11, 0
    ds_write_b32 v88, v11 offset:4
    v_mov_b32 v16, 0xff800000
    v_lshlrev_b32 v17, 2, v0
    v_and_b32 v17, 12, v17
    v_add_u32 v17, 118016, v17
    ds_write_b32 v17, v16
    s_waitcnt vmcnt(1)
    v_lshlrev_b32 v16, 16, v12
    v_and_b32 v17, s71, v12
    v_lshlrev_b32 v18, 16, v13
    v_and_b32 v19, s71, v13
    v_lshlrev_b32 v20, 16, v14
    v_and_b32 v21, s71, v14
    v_lshlrev_b32 v22, 16, v15
    v_and_b32 v23, s71, v15
    v_readfirstlane_b32 s52, v16
    s_mov_b32 s48, 0x3b000000
    s_nop 0
    v_subrev_f32 v24, s52, v16
    v_subrev_f32 v25, s52, v17
    v_subrev_f32 v26, s52, v18
    v_subrev_f32 v27, s52, v19
    v_subrev_f32 v28, s52, v20
    v_subrev_f32 v29, s52, v21
    v_subrev_f32 v30, s52, v22
    v_subrev_f32 v31, s52, v23
    v_pk_add_f32 v[32:33], v[24:25], v[26:27]
    v_pk_mul_f32 v[34:35], v[24:25], v[24:25]
    v_pk_add_f32 v[36:37], v[28:29], v[30:31]
    v_pk_fma_f32 v[34:35], v[26:27], v[26:27], v[34:35]
    v_pk_add_f32 v[32:33], v[32:33], v[36:37]
    v_pk_fma_f32 v[34:35], v[28:29], v[28:29], v[34:35]
    v_pk_fma_f32 v[34:35], v[30:31], v[30:31], v[34:35]
    v_add_f32 v32, v32, v33
    v_add_f32 v33, v34, v35
    s_nop 0
    v_add_f32_dpp v32, v32, v32 row_ror:8 row_mask:0xf bank_mask:0xf
    v_add_f32_dpp v33, v33, v33 row_ror:8 row_mask:0xf bank_mask:0xf
    s_nop 0
    v_add_f32_dpp v32, v32, v32 row_ror:4 row_mask:0xf bank_mask:0xf
    v_add_f32_dpp v33, v33, v33 row_ror:4 row_mask:0xf bank_mask:0xf
    s_nop 0
    v_add_f32_dpp v32, v32, v32 row_ror:2 row_mask:0xf bank_mask:0xf
    v_add_f32_dpp v33, v33, v33 row_ror:2 row_mask:0xf bank_mask:0xf
    s_nop 0
    v_add_f32_dpp v32, v32, v32 row_ror:1 row_mask:0xf bank_mask:0xf
    v_add_f32_dpp v33, v33, v33 row_ror:1 row_mask:0xf bank_mask:0xf
    s_nop 0
    s_nop 0
    v_permlane32_swap_b32 v32, v33
    v_add_f32 v32, v32, v33
    v_mov_b32 v33, v32
    s_nop 1
    v_permlane16_swap_b32 v32, v33
    v_add_f32 v32, v32, v33
    v_mul_f32 v32, s48, v32
    v_mov_b32 v33, v32
    s_nop 1
    v_permlane32_swap_b32 v32, v33
    v_fma_f32 v35, -v32, v32, v33
    v_add_f32 v34, s52, v32
    v_max_f32 v35, 0, v35
    v_cvt_pk_bf16_f32 v34, v34, v35
    v_and_b32 v35, s71, v34
    v_lshlrev_b32 v34, 16, v34
    v_add_f32 v35, 0x3727c5ac, v35
    v_cvt_pk_bf16_f32 v35, v35, v35
    v_and_b32 v35, s71, v35
    v_sqrt_f32 v35, v35
    v_sub_f32 v24, v16, v34
    v_sub_f32 v25, v17, v34
    v_sub_f32 v26, v18, v34
    v_sub_f32 v27, v19, v34
    v_sub_f32 v28, v20, v34
    v_sub_f32 v29, v21, v34
    v_sub_f32 v30, v22, v34
    v_sub_f32 v31, v23, v34
    v_cvt_pk_bf16_f32 v35, v35, v35
    v_and_b32 v35, s71, v35
    v_rcp_f32 v35, v35
    v_cvt_pk_bf16_f32 v12, v24, v25
    v_cvt_pk_bf16_f32 v13, v26, v27
    v_cvt_pk_bf16_f32 v14, v28, v29
    v_cvt_pk_bf16_f32 v15, v30, v31
    v_lshlrev_b32 v24, 16, v12
    v_and_b32 v25, s71, v12
    v_lshlrev_b32 v26, 16, v13
    v_and_b32 v27, s71, v13
    v_lshlrev_b32 v28, 16, v14
    v_and_b32 v29, s71, v14
    v_lshlrev_b32 v30, 16, v15
    v_and_b32 v31, s71, v15
    v_mul_f32 v24, v24, v35
    v_mul_f32 v25, v25, v35
    v_mul_f32 v26, v26, v35
    v_mul_f32 v27, v27, v35
    v_mul_f32 v28, v28, v35
    v_mul_f32 v29, v29, v35
    v_mul_f32 v30, v30, v35
    v_mul_f32 v31, v31, v35
    v_cvt_pk_bf16_f32 v12, v24, v25
    v_cvt_pk_bf16_f32 v13, v26, v27
    v_cvt_pk_bf16_f32 v14, v28, v29
    v_cvt_pk_bf16_f32 v15, v30, v31
    ds_write_b128 v9, v[12:15]
    s_waitcnt lgkmcnt(0)
    s_barrier
    s_setprio 0
    s_load_dword s57, s[32:33], 0
    s_lshr_b32 s52, s51, 1
    s_mul_i32 s61, s52, 448
    s_and_b32 s48, s51, 1
    s_lshl_b32 s52, s48, 8
    s_add_u32 s61, s61, s52
    s_lshl_b32 s52, s48, 4
    s_sub_u32 s62, 64, s52
    v_and_b32 v2, 0x70, v1
    v_lshlrev_b32 v3, 1, v0
    v_and_b32 v3, 32, v3
    v_xor_b32 v2, v2, v3
    v_lshrrev_b32 v3, 3, v0
    v_mul_u32_u24 v4, 3584, v3
    v_add_u32 v4, v4, v2
    s_add_u32 s52, s49, s48
    s_cmp_ge_u32 s52, 4
    s_cselect_b32 s68, 0x40000000, 0
    v_add_u32 v4, s68, v4
    v_xor_b32 v6, 64, v4
    v_lshl_or_b32 v7, v3, 10, v2
    v_xor_b32 v8, 64, v7
    s_mul_i32 s50, s53, 229376
    s_lshl_b32 s52, s49, 7
    s_add_u32 s50, s50, s52
    s_lshl_b32 s52, s61, 1
    s_add_u32 s50, s50, s52
    s_mov_b32 m0, 98304
    s_mov_b32 s26, 1835008
    s_mov_b32 s27, s7
    s_load_dwordx2 s[28:29], s[0:1], 64
    s_load_dwordx2 s[36:37], s[0:1], 56
    s_load_dwordx2 s[40:41], s[0:1], 72
    s_load_dwordx2 s[44:45], s[0:1], 80
    s_movk_i32 s60, 0xff
    s_mov_b32 s63, 0xffffff00
    s_mov_b32 s70, 0
    v_lshrrev_b32 v5, 4, v0
    v_and_b32 v1, 15, v0
    v_lshrrev_b32 v2, 2, v1
    v_and_b32 v3, 3, v0
    v_lshl_add_u32 v16, v5, 3, v2
    v_lshlrev_b32 v16, 7, v16
    v_lshlrev_b32 v17, 3, v3
    v_and_b32 v18, 2, v2
    v_lshlrev_b32 v18, 4, v18
    v_and_b32 v19, 1, v5
    v_lshlrev_b32 v19, 6, v19
    v_or_b32 v18, v18, v19
    v_xor_b32 v17, v17, v18
    v_or_b32 v16, v16, v17
    v_add_u32 v16, 98304, v16
    v_xor_b32 v17, 32, v16
    v_xor_b32 v18, 64, v16
    v_xor_b32 v19, 0x60, v16
    s_lshl_b32 s52, s53, 7
    s_add_u32 s52, s52, 114688
    v_lshl_add_u32 v20, v5, 4, s52
    v_lshl_add_u32 v21, v5, 4, s68
    s_lshl_b32 s66, s51, 13
    s_add_u32 s66, s66, 0x20000
    s_lshl_b32 s52, s53, 10
    s_add_u32 s67, s66, s52
    s_lshl_b32 s52, s49, 8
    s_add_u32 s67, s67, s52
    s_mov_b32 s30, s26
    s_mov_b32 s31, s7
    s_movk_i32 s38, 3584
    s_mov_b32 s39, s7
    s_mov_b32 s42, s6
    s_mov_b32 s43, s7
    s_mov_b32 s46, s6
    s_mov_b32 s47, s7
    ds_read_b128 v[56:59], v20
    ds_read_b128 v[60:63], v20 offset:64
    s_mul_i32 s52, s62, s49
    s_add_u32 s69, s61, s52
    v_lshl_add_u32 v11, v1, 2, v5
    v_add_lshl_u32 v22, v11, s69, 1
    v_and_b32 v23, 1, v5
    v_lshl_add_u32 v23, v3, 1, v23
    s_lshl_b32 s48, s51, 6
    s_lshl_b32 s56, s55, 3
    s_add_u32 s48, s48, s56
    v_add_lshl_u32 v23, v23, s48, 1
    v_lshlrev_b32 v80, 4, v1
    v_lshl_or_b32 v80, v5, 10, v80
    s_lshl_b32 s52, s52, 2
    s_add_u32 s64, s66, s52
    s_add_u32 s65, s64, 4096
    s_lshl_b32 s54, s69, 10
    s_lshl_b32 s52, s53, 7
    s_add_u32 s54, s54, s52
    s_waitcnt lgkmcnt(0)
    s_add_u32 s57, s57, 1
    s_lshr_b32 s48, s57, 7
    s_and_b32 s48, s48, 0xfe
    s_or_b32 s48, s48, 1
    s_and_b32 s59, s57, 0xff
    s_xor_b32 s73, s59, s48
    v_mov_b32 v10, s59
    v_mov_b32 v105, s73
    buffer_load_ushort v81, v22, s[36:39], 0 offen
    buffer_load_ushort v82, v23, s[40:43], 0 offen
    buffer_load_ushort v83, v23, s[4:7], 0 offen
    s_barrier
    buffer_load_dwordx4 v4, s[24:27], s50 offen nt lds
    s_add_u32 m0, m0, 0x400
    s_add_u32 s50, s50, 28672
    buffer_load_dwordx4 v6, s[24:27], s50 offen nt lds
    s_add_u32 m0, m0, 0x400
    s_add_u32 s50, s50, 28672
    buffer_load_dwordx4 v4, s[24:27], s50 offen nt lds
    s_add_u32 m0, m0, 0x400
    s_add_u32 s50, s50, 28672
    buffer_load_dwordx4 v6, s[24:27], s50 offen nt lds
    s_add_u32 m0, m0, 0x400
    s_add_u32 s50, s50, 28672
    buffer_load_dwordx4 v4, s[24:27], s50 offen nt lds
    s_add_u32 m0, m0, 0x400
    s_add_u32 s50, s50, 28672
    buffer_load_dwordx4 v6, s[24:27], s50 offen nt lds
    s_add_u32 m0, m0, 0x400
    s_add_u32 s50, s50, 28672
    buffer_load_dwordx4 v4, s[24:27], s50 offen nt lds
    s_add_u32 m0, m0, 0x400
    s_add_u32 s50, s50, 28672
    buffer_load_dwordx4 v6, s[24:27], s50 offen nt lds
    s_waitcnt vmcnt(0)
    ds_read_b64_tr_b16 v[24:25], v16 offset:0
    ds_read_b64_tr_b16 v[26:27], v16 offset:512
    ds_read_b64_tr_b16 v[28:29], v16 offset:4096
    ds_read_b64_tr_b16 v[30:31], v16 offset:4608
    ds_read_b64_tr_b16 v[32:33], v17 offset:0
    ds_read_b64_tr_b16 v[34:35], v17 offset:512
    ds_read_b64_tr_b16 v[36:37], v17 offset:4096
    ds_read_b64_tr_b16 v[38:39], v17 offset:4608
    s_waitcnt lgkmcnt(4)
    ds_read_b64_tr_b16 v[40:41], v18 offset:0
    ds_read_b64_tr_b16 v[42:43], v18 offset:512
    ds_read_b64_tr_b16 v[44:45], v18 offset:4096
    ds_read_b64_tr_b16 v[46:47], v18 offset:4608
    ds_read_b64_tr_b16 v[48:49], v19 offset:0
    ds_read_b64_tr_b16 v[50:51], v19 offset:512
    ds_read_b64_tr_b16 v[52:53], v19 offset:4096
    ds_read_b64_tr_b16 v[54:55], v19 offset:4608
    s_waitcnt lgkmcnt(12)
    v_mfma_f32_16x16x32_bf16 v[64:67], v[24:27], v[56:59], 0
    v_mfma_f32_16x16x32_bf16 v[64:67], v[28:31], v[60:63], v[64:67]
    s_waitcnt lgkmcnt(8)
    v_mfma_f32_16x16x32_bf16 v[68:71], v[32:35], v[56:59], 0
    v_mfma_f32_16x16x32_bf16 v[68:71], v[36:39], v[60:63], v[68:71]
    s_waitcnt lgkmcnt(4)
    v_mfma_f32_16x16x32_bf16 v[72:75], v[40:43], v[56:59], 0
    v_mfma_f32_16x16x32_bf16 v[72:75], v[44:47], v[60:63], v[72:75]
    s_waitcnt lgkmcnt(0)
    v_mfma_f32_16x16x32_bf16 v[76:79], v[48:51], v[56:59], 0
    v_mfma_f32_16x16x32_bf16 v[76:79], v[52:55], v[60:63], v[76:79]
    s_nop 1
    v_and_or_b32 v40, v64, s63, v10
    v_and_or_b32 v41, v65, s63, v105
    v_and_or_b32 v42, v66, s63, v10
    v_and_or_b32 v43, v67, s63, v105
    v_and_or_b32 v44, v68, s63, v10
    v_and_or_b32 v45, v69, s63, v105
    v_and_or_b32 v46, v70, s63, v10
    v_and_or_b32 v47, v71, s63, v105
    v_and_or_b32 v48, v72, s63, v10
    v_and_or_b32 v49, v73, s63, v105
    v_and_or_b32 v50, v74, s63, v10
    v_and_or_b32 v51, v75, s63, v105
    s_nop 3
    v_and_or_b32 v52, v76, s63, v10
    v_and_or_b32 v53, v77, s63, v105
    v_and_or_b32 v54, v78, s63, v10
    v_and_or_b32 v55, v79, s63, v105
    s_barrier
    ds_read_b32 v24, v88 offset:4
    s_waitcnt lgkmcnt(0)
    v_readfirstlane_b32 s58, v24
    s_mov_b32 exec_lo, 0x10001
    s_mov_b32 exec_hi, exec_lo
    s_cmp_lg_u32 s58, 0
    s_cbranch_scc1 L_hglob
    buffer_store_dwordx4 v[40:43], v21, s[32:35], s67 offen offset:0
    buffer_store_dwordx4 v[44:47], v21, s[32:35], s67 offen offset:64
    buffer_store_dwordx4 v[48:51], v21, s[32:35], s67 offen offset:128
    buffer_store_dwordx4 v[52:55], v21, s[32:35], s67 offen offset:192
L_hpubd:
    s_mov_b64 exec, -1
    s_mov_b32 m0, 106496
    s_cmp_eq_u32 s62, 64
    s_cselect_b32 s56, 0, 0x40000000
    buffer_load_dwordx4 v7, s[28:31], s54 offen nt lds
    s_add_u32 m0, m0, 0x400
    s_add_u32 s54, s54, 8192
    buffer_load_dwordx4 v8, s[28:31], s54 offen nt lds
    s_add_u32 m0, m0, 0x400
    s_add_u32 s54, s54, 8192
    buffer_load_dwordx4 v7, s[28:31], s54 offen nt lds
    s_add_u32 m0, m0, 0x400
    s_add_u32 s54, s54, 8192
    buffer_load_dwordx4 v8, s[28:31], s54 offen nt lds
    s_add_u32 m0, m0, 0x400
    s_add_u32 s54, s54, 8192
    buffer_load_dwordx4 v7, s[28:31], s54 offen nt lds
    s_add_u32 m0, m0, 0x400
    s_add_u32 s54, s54, 8192
    buffer_load_dwordx4 v8, s[28:31], s54 offen nt lds
    s_add_u32 m0, m0, 0x400
    s_add_u32 s54, s54, 8192
    v_add_u32 v7, s56, v7
    v_add_u32 v8, s56, v8
    buffer_load_dwordx4 v7, s[28:31], s54 offen nt lds
    s_add_u32 m0, m0, 0x400
    s_add_u32 s54, s54, 8192
    buffer_load_dwordx4 v8, s[28:31], s54 offen nt lds
    v_add_u32 v16, 8192, v16
    v_add_u32 v17, 8192, v17
    v_add_u32 v18, 8192, v18
    v_add_u32 v19, 8192, v19
    v_lshlrev_b32 v84, 1, v11
    v_add_u32 v84, 120576, v84
    v_lshlrev_b32 v85, 4, v5
    v_add_u32 v85, 120576, v85
    v_add_u32 v86, 256, v85
    s_barrier
    s_barrier
    v_cmp_gt_u32 vcc, s62, v11
    s_mov_b64 s[68:69], vcc
    buffer_load_dwordx4 v[24:27], v80, s[32:35], s64 offen nt
    buffer_load_dwordx4 v[28:31], v80, s[32:35], s65 offen nt
    s_barrier
    s_waitcnt vmcnt(0)
L_hchk:
    v_bitop3_b32 v32, v24, v26, s59 bitop3:0x7e
    v_bitop3_b32 v33, v25, v27, s73 bitop3:0x7e
    v_bitop3_b32 v34, v28, v30, s59 bitop3:0x7e
    v_or3_b32 v32, v32, v33, v34
    v_bitop3_b32 v33, v29, v31, s73 bitop3:0x7e
    v_bitop3_b32 v32, v32, v33, s60 bitop3:0xa8
    v_cmp_ne_u32 vcc, 0, v32
    s_and_b64 vcc, vcc, s[68:69]
    s_cbranch_vccnz L_hretry
L_hok:
    v_and_b32 v24, s63, v24
    v_and_b32 v25, s63, v25
    v_and_b32 v26, s63, v26
    v_and_b32 v27, s63, v27
    v_and_b32 v28, s63, v28
    v_and_b32 v29, s63, v29
    v_and_b32 v30, s63, v30
    v_and_b32 v31, s63, v31
    v_add_f32 v24, v24, v28
    v_add_f32 v25, v25, v29
    v_add_f32 v26, v26, v30
    v_add_f32 v27, v27, v31
    s_nop 1
    v_permlane32_swap_b32 v24, v26
    v_permlane32_swap_b32 v25, v27
    v_add_f32 v24, v24, v26
    v_add_f32 v25, v25, v27
    s_nop 1
    v_permlane16_swap_b32 v24, v25
    v_add_f32 v24, v24, v25
    v_cvt_pk_bf16_f32 v24, v24, v24
    v_and_b32 v24, s71, v24
    v_lshlrev_b32 v81, 16, v81
    v_add_f32 v24, v24, v81
    v_cvt_pk_bf16_f32 v24, v24, v24
    v_and_b32 v24, s71, v24
    v_mul_f32 v25, v24, v24
    v_mov_b32 v26, 0x3d372713
    v_fma_f32 v25, v25, v26, 1.0
    v_mul_f32 v25, v25, v24
    v_mul_f32 v25, 0xc0135761, v25
    v_exp_f32 v25, v25
    s_nop 0
    v_add_f32 v25, 1.0, v25
    v_rcp_f32 v25, v25
    s_nop 0
    v_mul_f32 v24, v24, v25
    v_cvt_pk_bf16_f32 v24, v24, v24
    v_cndmask_b32 v24, 0, v24, s[68:69]
    ds_write_b16 v84, v24
    s_waitcnt lgkmcnt(0)
    ds_read_b128 v[56:59], v85
    ds_read_b128 v[60:63], v85 offset:64
    v_and_b32 v36, 31, v0
    v_lshrrev_b32 v37, 5, v0
    v_lshlrev_b32 v87, 3, v36
    v_lshl_add_u32 v84, v37, 10, v87
    v_add_u32 v84, 118272, v84
    v_add_u32 v87, 120832, v87
    s_lshl_b32 s52, s51, 2
    s_add_u32 s52, s52, s49
    s_lshl_b32 s66, s53, 14
    s_add_u32 s66, s66, 0x40000
    s_lshl_b32 s64, s51, 14
    s_add_u32 s64, s64, 0x40000
    v_lshlrev_b32 v85, 4, v36
    s_lshl_b32 s52, s52, 9
    s_add_u32 s66, s66, s52
    s_lshl_b32 s52, s55, 6
    s_add_u32 s64, s64, s52
    s_add_u32 s65, s64, 8192
    v_lshrrev_b32 v80, 2, v0
    v_lshlrev_b32 v80, 9, v80
    v_lshl_or_b32 v80, v3, 4, v80
    v_cmp_gt_u32 vcc, 32, v0
    s_waitcnt vmcnt(0)
    s_nop 0
    v_cndmask_b32 v82, v82, v83, vcc
    v_lshlrev_b32 v82, 16, v82
    ds_read_b64_tr_b16 v[24:25], v16 offset:0
    ds_read_b64_tr_b16 v[26:27], v16 offset:512
    ds_read_b64_tr_b16 v[28:29], v16 offset:4096
    ds_read_b64_tr_b16 v[30:31], v16 offset:4608
    ds_read_b64_tr_b16 v[32:33], v17 offset:0
    ds_read_b64_tr_b16 v[34:35], v17 offset:512
    ds_read_b64_tr_b16 v[36:37], v17 offset:4096
    ds_read_b64_tr_b16 v[38:39], v17 offset:4608
    s_waitcnt lgkmcnt(4)
    ds_read_b64_tr_b16 v[40:41], v18 offset:0
    ds_read_b64_tr_b16 v[42:43], v18 offset:512
    ds_read_b64_tr_b16 v[44:45], v18 offset:4096
    ds_read_b64_tr_b16 v[46:47], v18 offset:4608
    ds_read_b64_tr_b16 v[48:49], v19 offset:0
    ds_read_b64_tr_b16 v[50:51], v19 offset:512
    ds_read_b64_tr_b16 v[52:53], v19 offset:4096
    ds_read_b64_tr_b16 v[54:55], v19 offset:4608
    s_waitcnt lgkmcnt(12)
    v_mfma_f32_16x16x32_bf16 v[64:67], v[24:27], v[56:59], 0
    v_mfma_f32_16x16x32_bf16 v[64:67], v[28:31], v[60:63], v[64:67]
    s_waitcnt lgkmcnt(8)
    v_mfma_f32_16x16x32_bf16 v[68:71], v[32:35], v[56:59], 0
    v_mfma_f32_16x16x32_bf16 v[68:71], v[36:39], v[60:63], v[68:71]
    s_waitcnt lgkmcnt(4)
    v_mfma_f32_16x16x32_bf16 v[72:75], v[40:43], v[56:59], 0
    v_mfma_f32_16x16x32_bf16 v[72:75], v[44:47], v[60:63], v[72:75]
    s_waitcnt lgkmcnt(0)
    v_mfma_f32_16x16x32_bf16 v[76:79], v[48:51], v[56:59], 0
    v_mfma_f32_16x16x32_bf16 v[76:79], v[52:55], v[60:63], v[76:79]
    s_mov_b32 exec_lo, 0x10001
    s_mov_b32 exec_hi, exec_lo
    s_cmp_ge_u32 s2, 64
    ds_write_b128 v86, v[64:67] offset:0
    ds_write_b128 v86, v[68:71] offset:64
    ds_write_b128 v86, v[72:75] offset:128
    s_nop 3
    ds_write_b128 v86, v[76:79] offset:192
    s_mov_b64 exec, -1
    s_waitcnt lgkmcnt(0)
    ds_read_b64 v[34:35], v87
    s_barrier
    ds_read_b64 v[24:25], v84 offset:0
    ds_read_b64 v[26:27], v84 offset:256
    ds_read_b64 v[28:29], v84 offset:512
    ds_read_b64 v[30:31], v84 offset:768
    s_waitcnt lgkmcnt(2)
    v_pk_add_f32 v[24:25], v[24:25], v[26:27]
    s_waitcnt lgkmcnt(0)
    v_pk_add_f32 v[28:29], v[28:29], v[30:31]
    v_pk_add_f32 v[32:33], v[24:25], v[28:29]
    v_and_or_b32 v34, v34, s63, v10
    v_and_or_b32 v35, v35, s63, v105
    v_permlane32_swap_b32 v32, v33
    v_add_f32 v32, v32, v33
    v_mov_b32 v33, v32
    s_nop 1
    v_permlane32_swap_b32 v32, v33
    s_mov_b32 exec_lo, -1
    s_mov_b32 exec_hi, 0
    v_and_or_b32 v32, v32, s63, v10
    v_and_or_b32 v33, v33, s63, v105
    buffer_store_dwordx4 v[32:35], v85, s[32:35], s66 offen sc1
    s_mov_b64 exec, -1
    s_cbranch_scc1 L_auxend
    s_waitcnt vmcnt(0)
    buffer_load_dwordx4 v[24:27], v80, s[32:35], s64 offen sc1
    buffer_load_dwordx4 v[28:31], v80, s[32:35], s65 offen sc1
    s_waitcnt vmcnt(0)
L_apoll:
    v_bitop3_b32 v56, v24, v26, s59 bitop3:0x7e
    v_bitop3_b32 v57, v25, v27, s73 bitop3:0x7e
    v_bitop3_b32 v58, v28, v30, s59 bitop3:0x7e
    v_or3_b32 v56, v56, v57, v58
    v_bitop3_b32 v57, v29, v31, s73 bitop3:0x7e
    v_bitop3_b32 v56, v56, v57, s60 bitop3:0xa8
    v_cmp_ne_u32 vcc, 0, v56
    s_cbranch_vccz L_apoll_ok
    buffer_load_dwordx4 v[24:27], v80, s[32:35], s64 offen sc1
    buffer_load_dwordx4 v[28:31], v80, s[32:35], s65 offen sc1
    s_add_u32 s70, s70, 1
    s_cmp_lt_u32 s70, 0x80000
    s_waitcnt vmcnt(0)
    s_cbranch_scc1 L_apoll
L_apoll_ok:
    v_and_b32 v24, s63, v24
    v_and_b32 v25, s63, v25
    v_and_b32 v26, s63, v26
    v_and_b32 v27, s63, v27
    v_and_b32 v28, s63, v28
    v_and_b32 v29, s63, v29
    v_and_b32 v30, s63, v30
    v_and_b32 v31, s63, v31
    v_pk_add_f32 v[24:25], v[24:25], v[28:29]
    v_pk_add_f32 v[26:27], v[26:27], v[30:31]
    s_nop 1
    v_permlane32_swap_b32 v24, v26
    v_permlane32_swap_b32 v25, v27
    v_add_f32 v24, v24, v26
    v_add_f32 v25, v25, v27
    s_nop 1
    v_permlane16_swap_b32 v24, v25
    v_add_f32 v24, v24, v25
    s_nop 1
    v_add_f32_dpp v24, v24, v24 row_ror:4 row_mask:0xf bank_mask:0xf
    s_nop 1
    v_add_f32_dpp v24, v24, v24 row_ror:8 row_mask:0xf bank_mask:0xf
    v_cvt_pk_bf16_f32 v24, v24, v24
    v_and_b32 v24, s71, v24
    v_add_f32 v24, v24, v82
    v_cvt_pk_bf16_f32 v24, v24, v24
    v_and_b32 v24, s71, v24
    v_mov_b32 v25, v24
    s_nop 1
    v_permlane32_swap_b32 v24, v25
    v_add_f32 v24, v24, v25
    v_cvt_pk_bf16_f32 v24, v24, v24
    s_mov_b32 exec_lo, 0xf000f
    s_mov_b32 exec_hi, 0x0
    buffer_store_short v24, v23, s[44:47], 0 offen
    s_cmp_lg_u32 s2, 0
    s_cbranch_scc1 L_auxend
    s_mov_b64 exec, 1
    v_mov_b32 v60, s57
    v_mov_b32 v61, 0
    buffer_store_dword v60, v61, s[32:35], 0 offen
L_auxend:
L_end:
    s_endpgm
L_hretry:
    s_add_u32 s70, s70, 1
    s_lshl_b32 s48, s58, 8
    s_add_u32 s48, s48, s70
    s_cmp_lt_u32 s48, 24
    s_cbranch_scc0 L_hwide
    buffer_load_dwordx4 v[24:27], v80, s[32:35], s64 offen nt
    buffer_load_dwordx4 v[28:31], v80, s[32:35], s65 offen nt
    s_waitcnt vmcnt(0)
    s_branch L_hchk
L_hwide:
    buffer_load_dwordx4 v[24:27], v80, s[32:35], s64 offen sc1
    buffer_load_dwordx4 v[28:31], v80, s[32:35], s65 offen sc1
    s_cmp_lt_u32 s70, 0x80000
    s_waitcnt vmcnt(0)
    s_cbranch_scc1 L_hchk
    s_branch L_hok
L_hglob:
    s_add_u32 s64, s64, 0x100000
    s_add_u32 s65, s65, 0x100000
    s_add_u32 s67, s67, 0x100000
    buffer_store_dwordx4 v[40:43], v21, s[32:35], s67 offen offset:0 sc1
    buffer_store_dwordx4 v[44:47], v21, s[32:35], s67 offen offset:64 sc1
    buffer_store_dwordx4 v[48:51], v21, s[32:35], s67 offen offset:128 sc1
    buffer_store_dwordx4 v[52:55], v21, s[32:35], s67 offen offset:192 sc1
    s_branch L_hpubd
L_codeend:
.section .rodata,"a"
.p2align 6
.amdhsa_kernel parallel_sum__sliding_block_cached__dense_activation_gelu__decode_kernel
  .amdhsa_next_free_vgpr 112
  .amdhsa_next_free_sgpr 102
  .amdhsa_accum_offset 112
  .amdhsa_group_segment_fixed_size 0
  .amdhsa_kernarg_size 104
  .amdhsa_user_sgpr_count 2
  .amdhsa_user_sgpr_kernarg_segment_ptr 1
  .amdhsa_system_sgpr_workgroup_id_x 1
  .amdhsa_float_denorm_mode_32 3
.end_amdhsa_kernel
```
